```python
import torch

def _softmax(x, axis=-1):
    return torch.softmax(x, dim=axis)
def _gelu(x):
    return torch.nn.functional.gelu(x, approximate="tanh")
def _silu(x):
    return torch.nn.functional.silu(x)
def _sigmoid(x):
    return torch.sigmoid(x)
def _layernorm(x, axis=-1, eps=1e-5):
    m = x.mean(dim=axis, keepdim=True)
    v = x.var(dim=axis, keepdim=True, unbiased=False)
    return (x - m) / torch.sqrt(v + eps)
def _scatter_add(tgt, idx, src, axis=0):
    return tgt.clone().index_add_(axis, idx, src)
def _segment_sum(src, seg, n):
    out = torch.zeros((n,) + src.shape[1:], dtype=src.dtype)
    return out.index_add_(0, seg, src)
def _pad(x, pw):
    flat = tuple(v for pair in reversed(pw) for v in pair)
    return torch.nn.functional.pad(x, flat)

kernel_name = 'standalone__sliding_local_fixed_window__prompt'

def setup_inputs():

    _w = (lambda a: (lambda t: t.to(torch.bfloat16) if t.is_floating_point() else t)(torch.as_tensor(a)))
    B, H, S, D = 1, 32, 2048, 192
    return {
        "q": _w((lambda *s: torch.randn(*s, dtype=torch.bfloat16) * 0.8)(B, H, S, D)),
        "k": _w((lambda *s: torch.randn(*s, dtype=torch.bfloat16) * 0.8)(B, H, S, D)),
        "v": _w((lambda *s: torch.randn(*s, dtype=torch.bfloat16) * 0.05)(B, H, S, D)),
    }

def reference(q, k, v):
    B, H, S, D = q.shape
    w = 32
    pos = torch.arange(S)
    rel = pos[:, None] - pos[None, :]
    mask = (rel >= 0) & (rel < w)
    scores = torch.einsum("bhqd,bhkd->bhqk", q, k) * (D ** -0.5)
    scores = torch.where(mask[None, None], scores, (lambda x, dt: x.to(dt))(torch.as_tensor(-1e9), q.dtype))
    p = _softmax(scores, axis=-1)
    return torch.einsum("bhqk,bhkd->bhqd", p, v)
```

```asm
; @launch grid=(256,1,1) block=(448,1,1) lds=161536
.amdgcn_target "amdgcn-amd-amdhsa--gfx950"
.text
.globl standalone__sliding_local_fixed_window__prompt_kernel
.p2align 12
.p2align 8
.type standalone__sliding_local_fixed_window__prompt_kernel,@function
standalone__sliding_local_fixed_window__prompt_kernel:
    s_cmp_ge_u32 s2, 256
    s_cbranch_scc1 L_end
    s_load_dwordx2 s[16:17], s[0:1], 8
    s_load_dwordx2 s[12:13], s[0:1], 0
    s_load_dwordx2 s[20:21], s[0:1], 16
    s_load_dwordx2 s[24:25], s[0:1], 24
    v_and_b32 v7, 63, v0
    v_readfirstlane_b32 s28, v0
    v_lshrrev_b32 v65, 1, v7
    v_and_b32 v65, 28, v65
    s_movk_i32 s50, 0x50
    v_mov_b32 v67, 3072
    s_mov_b32 s49, 0x22000000
    v_bfe_u32 v66, s49, v65, 3
    v_xor_b32 v66, v66, v7
    v_lshlrev_b32 v1, 4, v66
    v_xad_u32 v4, v1, s50, v67
    s_mov_b32 s49, 0x44442222
    v_bfe_u32 v66, s49, v65, 3
    v_xor_b32 v66, v66, v7
    v_lshlrev_b32 v2, 4, v66
    v_xad_u32 v5, v2, s50, v67
    s_mov_b32 s49, 0x66666644
    v_bfe_u32 v66, s49, v65, 3
    v_xor_b32 v66, v66, v7
    v_lshlrev_b32 v3, 4, v66
    v_xad_u32 v6, v3, s50, v67
    s_mov_b32 s18, 25165824
    s_mov_b32 s19, 0x20000
    s_mov_b32 s14, s18
    s_mov_b32 s15, s19
    s_mov_b32 s22, s18
    s_mov_b32 s23, s19
    s_mov_b32 s26, s18
    s_mov_b32 s27, s19
    s_and_b32 s47, s2, 7
    s_lshr_b32 s48, s2, 6
    s_lshl3_add_u32 s47, s48, s47
    s_bfe_u32 s33, s2, 0x30003
    s_mul_i32 s32, s47, 786432
    s_lshl_b32 s48, s33, 4
    s_bitcmp1_b32 s33, 0
    s_cselect_b32 s29, -1, 1
    s_cselect_b32 s30, 15, -2
    s_cselect_b32 s31, 15, 0
    s_add_i32 s30, s30, s48
    s_add_i32 s31, s31, s48
    s_mulk_i32 s29, 6144
    s_mulk_i32 s30, 6144
    s_mulk_i32 s31, 6144
    s_add_i32 s30, s30, s32
    s_add_i32 s31, s31, s32
    s_lshr_b32 s28, s28, 6
    s_cmp_lg_u32 s28, 0
    s_cbranch_scc0 L_loader
    v_lshlrev_b32 v26, 2, v0
    v_add_u32 v26, 159744, v26
    s_sub_u32 s46, s28, 4
    s_min_i32 s46, s46, 0
    v_mov_b32 v27, s46
    ds_write_b32 v26, v27
    s_waitcnt lgkmcnt(0)
    s_barrier
    s_branch L_compute
L_loader:
    s_setprio 3
    s_max_i32 s66, s30, s32
    s_add_i32 s47, s66, s29
    s_add_i32 s54, s30, s29
    s_add_i32 s67, s54, s29
    s_mov_b32 s54, s66
    s_mov_b32 s55, 0
    s_waitcnt lgkmcnt(0)
L_pre:
    s_add_u32 m0, s55, 0
    s_nop 0
    buffer_load_dwordx4 v1, s[16:19], s54 offen nt lds
    buffer_load_dwordx4 v2, s[16:19], s54 offen offset:1024 nt lds
    buffer_load_dwordx4 v3, s[16:19], s54 offen offset:2048 nt lds
    s_add_u32 m0, s55, 3072
    s_nop 0
    buffer_load_dwordx4 v4, s[16:19], s54 offen nt lds
    buffer_load_dwordx4 v5, s[16:19], s54 offen offset:1024 nt lds
    buffer_load_dwordx4 v6, s[16:19], s54 offen offset:2048 nt lds
    s_add_i32 s54, s54, s29
    s_addk_i32 s55, 6144
    s_cmpk_eq_u32 s55, 12288
    s_cselect_b32 s54, s67, s54
    s_cmpk_lt_u32 s55, 24576
    s_cbranch_scc1 L_pre
    v_lshlrev_b32 v25, 2, v0
    v_add_u32 v25, 159744, v25
    v_mov_b32 v27, 0
    ds_write_b32 v25, v27
    v_and_b32 v26, 3, v7
    v_lshlrev_b32 v26, 8, v26
    v_add_u32 v26, 160000, v26
    s_mov_b32 s70, 0xc0000f
    s_mov_b32 s71, 0x400002
    s_mov_b32 s69, 27
    s_mov_b32 s68, -24
    s_mov_b32 s46, s54
    s_mov_b32 s55, 24576
    s_mov_b32 s34, 4
    s_mov_b64 s[72:73], s[16:17]
    s_mov_b32 s74, s18
    s_mov_b32 s75, s19
    s_mov_b32 s76, 0x4040020
    s_mov_b32 s77, 0x140014
    s_waitcnt lgkmcnt(0)
    s_barrier
L_ld:
    s_add_u32 m0, s55, 0
    s_getreg_b32 s49, hwreg(HW_REG_IB_STS)
    s_and_b32 s49, s49, s70
    s_cmp_le_u32 s49, s71
    s_cbranch_scc0 L_dw0
L_dk0:
    buffer_load_dwordx4 v1, s[72:75], s46 offen nt lds
    buffer_load_dwordx4 v2, s[72:75], s46 offen offset:1024 nt lds
    buffer_load_dwordx4 v3, s[72:75], s46 offen offset:2048 nt lds
    ds_read_b32 v27, v26
    s_add_u32 m0, s55, 3072
    s_getreg_b32 s49, hwreg(HW_REG_IB_STS)
    s_and_b32 s49, s49, s70
    s_cmp_le_u32 s49, s71
    s_cbranch_scc0 L_dw3
L_dk3:
    buffer_load_dwordx4 v4, s[72:75], s46 offen nt lds
    buffer_load_dwordx4 v5, s[72:75], s46 offen offset:1024 nt lds
    buffer_load_dwordx4 v6, s[72:75], s46 offen offset:2048 nt lds
    s_lshr_b32 s50, s49, 18
    s_add_u32 s49, s49, s50
    s_and_b32 s49, s49, 63
    s_sub_u32 s49, s69, s49
    v_mov_b32 v28, s49
    ds_write_b32 v25, v28
    s_add_u32 s69, s69, 6
    s_add_u32 s34, s34, 1
    s_add_i32 s46, s46, s29
    s_add_u32 s55, s55, 6144
    s_waitcnt lgkmcnt(1)
    v_cmp_ge_i32 vcc, s68, v27
    s_add_i32 s68, s68, 1
    s_cbranch_vccnz L_free_again
L_free_ok:
    s_bitcmp1_b64 s[76:77], s34
    s_cbranch_scc0 L_ld
    s_branch L_event
L_dw0:
    s_getreg_b32 s49, hwreg(HW_REG_IB_STS)
    s_and_b32 s49, s49, s70
    s_cmp_le_u32 s49, s71
    s_cbranch_scc1 L_dk0
    s_getreg_b32 s49, hwreg(HW_REG_IB_STS)
    s_and_b32 s49, s49, s70
    s_cmp_le_u32 s49, s71
    s_cbranch_scc1 L_dk0
    s_getreg_b32 s49, hwreg(HW_REG_IB_STS)
    s_and_b32 s49, s49, s70
    s_cmp_le_u32 s49, s71
    s_cbranch_scc1 L_dk0
    s_getreg_b32 s49, hwreg(HW_REG_IB_STS)
    s_and_b32 s49, s49, s70
    s_cmp_le_u32 s49, s71
    s_cbranch_scc1 L_dk0
    s_getreg_b32 s49, hwreg(HW_REG_IB_STS)
    s_and_b32 s49, s49, s70
    s_cmp_le_u32 s49, s71
    s_cbranch_scc1 L_dk0
    s_waitcnt vmcnt(33)
    s_branch L_dk0
L_dw3:
    s_getreg_b32 s49, hwreg(HW_REG_IB_STS)
    s_and_b32 s49, s49, s70
    s_cmp_le_u32 s49, s71
    s_cbranch_scc1 L_dk3
    s_getreg_b32 s49, hwreg(HW_REG_IB_STS)
    s_and_b32 s49, s49, s70
    s_cmp_le_u32 s49, s71
    s_cbranch_scc1 L_dk3
    s_getreg_b32 s49, hwreg(HW_REG_IB_STS)
    s_and_b32 s49, s49, s70
    s_cmp_le_u32 s49, s71
    s_cbranch_scc1 L_dk3
    s_getreg_b32 s49, hwreg(HW_REG_IB_STS)
    s_and_b32 s49, s49, s70
    s_cmp_le_u32 s49, s71
    s_cbranch_scc1 L_dk3
    s_getreg_b32 s49, hwreg(HW_REG_IB_STS)
    s_and_b32 s49, s49, s70
    s_cmp_le_u32 s49, s71
    s_cbranch_scc1 L_dk3
    s_waitcnt vmcnt(33)
    s_branch L_dk3
L_free_again:
    ds_read_b32 v27, v26
    s_waitcnt lgkmcnt(0)
    v_cmp_gt_i32 vcc, s68, v27
    s_cbranch_vccnz L_free_again
    s_branch L_free_ok
L_event:
    s_cmp_eq_u32 s34, 18
    s_cselect_b64 s[72:73], s[12:13], s[72:73]
    s_cselect_b32 s46, s31, s46
    s_cmp_eq_u32 s34, 26
    s_cselect_b32 s55, 110592, s55
    s_cmp_eq_u32 s34, 34
    s_cselect_b64 s[72:73], s[20:21], s[72:73]
    s_cselect_b32 s46, s66, s46
    s_cselect_b32 s55, 0, s55
    s_cselect_b32 s68, -2, s68
    s_cmp_eq_u32 s34, 36
    s_cselect_b32 s46, s67, s46
    s_cmp_eq_u32 s34, 50
    s_cselect_b32 s71, s70, s71
    s_cmp_lt_u32 s34, 52
    s_cbranch_scc1 L_ld
    v_mov_b32 v28, 264
    s_waitcnt vmcnt(48)
    ds_write_b32 v25, v28
    v_mov_b32 v27, 267
    s_waitcnt vmcnt(45)
    v_mov_b32 v28, 270
    s_waitcnt vmcnt(42)
    ds_write_b32 v25, v28
    v_mov_b32 v27, 273
    s_waitcnt vmcnt(39)
    v_mov_b32 v28, 276
    s_waitcnt vmcnt(36)
    ds_write_b32 v25, v28
    v_mov_b32 v27, 279
    s_waitcnt vmcnt(33)
    v_mov_b32 v28, 282
    s_waitcnt vmcnt(30)
    ds_write_b32 v25, v28
    v_mov_b32 v27, 285
    s_waitcnt vmcnt(27)
    v_mov_b32 v28, 288
    s_waitcnt vmcnt(24)
    ds_write_b32 v25, v28
    ds_write_b32 v25, v28 offset:1280
    v_mov_b32 v27, 291
    s_waitcnt vmcnt(21)
    v_mov_b32 v28, 294
    s_waitcnt vmcnt(18)
    ds_write_b32 v25, v28
    v_mov_b32 v27, 297
    s_waitcnt vmcnt(15)
    v_mov_b32 v28, 300
    s_waitcnt vmcnt(12)
    ds_write_b32 v25, v28
    v_mov_b32 v27, 303
    s_waitcnt vmcnt(9)
    v_mov_b32 v28, 306
    s_waitcnt vmcnt(6)
    ds_write_b32 v25, v28
    v_mov_b32 v27, 309
    s_waitcnt vmcnt(3)
    v_mov_b32 v28, 312
    s_waitcnt vmcnt(0)
    ds_write_b32 v25, v28
    s_branch L_fin
L_storer:
    v_and_b32 v26, 3, v7
    v_lshlrev_b32 v26, 8, v26
    v_add_u32 v26, 160000, v26
    v_lshlrev_b32 v20, 4, v7
    v_add_u32 v20, 110592, v20
    v_lshlrev_b32 v8, 2, v7
    v_add_u32 v8, 161280, v8
    s_movk_i32 s53, 288
    v_mov_b32 v25, 161024
    s_cmp_eq_u32 s28, 5
    s_cselect_b32 s46, 32, 34
    s_cselect_b32 s47, 0, 8
    s_mul_i32 s47, s47, s29
    s_add_i32 s31, s31, s47
    v_mov_b32 v28, 1
L_ofreea:
    s_sleep 1
    ds_read_b32 v27, v26
    s_waitcnt lgkmcnt(0)
    v_cmp_gt_i32 vcc, s46, v27
    s_cbranch_vccnz L_ofreea
    ds_read_b128 v[32:35], v20 offset:0
    ds_read_b128 v[36:39], v20 offset:1024
    ds_read_b128 v[40:43], v20 offset:2048
    ds_read_b128 v[44:47], v20 offset:3072
    ds_read_b128 v[48:51], v20 offset:4096
    ds_read_b128 v[52:55], v20 offset:5120
    ds_read_b128 v[56:59], v20 offset:6144
    ds_read_b128 v[60:63], v20 offset:7168
    ds_read_b128 v[64:67], v20 offset:8192
    ds_read_b128 v[68:71], v20 offset:9216
    ds_read_b128 v[72:75], v20 offset:10240
    ds_read_b128 v[76:79], v20 offset:11264
    s_waitcnt lgkmcnt(0)
    ds_read_b128 v[80:83], v20 offset:12288
    ds_read_b128 v[84:87], v20 offset:13312
    ds_read_b128 v[88:91], v20 offset:14336
    ds_read_b128 v[92:95], v20 offset:15360
    ds_read_b128 v[96:99], v20 offset:16384
    ds_read_b128 v[100:103], v20 offset:17408
    ds_read_b128 v[104:107], v20 offset:18432
    ds_read_b128 v[108:111], v20 offset:19456
    ds_read_b128 v[112:115], v20 offset:20480
    ds_read_b128 v[116:119], v20 offset:21504
    ds_read_b128 v[120:123], v20 offset:22528
    ds_read_b128 v[124:127], v20 offset:23552
    s_waitcnt lgkmcnt(0)
    s_cmp_eq_u32 s28, 5
    s_cbranch_scc0 L_st_wait
    ds_write_b32 v8, v28
    v_mov_b32 v10, 2
L_ofreeb:
    s_sleep 1
    ds_read_b32 v27, v26
    s_waitcnt lgkmcnt(0)
    v_cmp_gt_i32 vcc, 33, v27
    s_cbranch_vccnz L_ofreeb
    ds_read_b128 v[128:131], v20 offset:24576
    ds_read_b128 v[132:135], v20 offset:25600
    ds_read_b128 v[136:139], v20 offset:26624
    ds_read_b128 v[140:143], v20 offset:27648
    ds_read_b128 v[144:147], v20 offset:28672
    ds_read_b128 v[148:151], v20 offset:29696
    ds_read_b128 v[152:155], v20 offset:30720
    ds_read_b128 v[156:159], v20 offset:31744
    ds_read_b128 v[160:163], v20 offset:32768
    ds_read_b128 v[164:167], v20 offset:33792
    ds_read_b128 v[168:171], v20 offset:34816
    ds_read_b128 v[172:175], v20 offset:35840
    s_waitcnt lgkmcnt(0)
    ds_read_b128 v[176:179], v20 offset:36864
    ds_read_b128 v[180:183], v20 offset:37888
    ds_read_b128 v[184:187], v20 offset:38912
    ds_read_b128 v[188:191], v20 offset:39936
    ds_read_b128 v[192:195], v20 offset:40960
    ds_read_b128 v[196:199], v20 offset:41984
    ds_read_b128 v[200:203], v20 offset:43008
    ds_read_b128 v[204:207], v20 offset:44032
    ds_read_b128 v[208:211], v20 offset:45056
    ds_read_b128 v[212:215], v20 offset:46080
    ds_read_b128 v[216:219], v20 offset:47104
    ds_read_b128 v[220:223], v20 offset:48128
    s_waitcnt lgkmcnt(0)
    ds_write_b32 v8, v10
L_st_wait:
    s_cmp_ge_u32 s35, s53
    s_cbranch_scc1 L_go0
L_poll0:
    ds_read_b32 v27, v25
    s_waitcnt lgkmcnt(0)
    v_readfirstlane_b32 s35, v27
    s_nop 0
    s_cmp_ge_u32 s35, s53
    s_cbranch_scc1 L_go0
    s_sleep 1
    s_branch L_poll0
L_go0:
    buffer_store_dwordx4 v[32:35], v1, s[24:27], s31 offen sc1
    buffer_store_dwordx4 v[36:39], v2, s[24:27], s31 offen offset:1024 sc1
    buffer_store_dwordx4 v[40:43], v3, s[24:27], s31 offen offset:2048 sc1
    buffer_store_dwordx4 v[44:47], v4, s[24:27], s31 offen sc1
    buffer_store_dwordx4 v[48:51], v5, s[24:27], s31 offen offset:1024 sc1
    buffer_store_dwordx4 v[52:55], v6, s[24:27], s31 offen offset:2048 sc1
    s_add_i32 s31, s31, s29
    buffer_store_dwordx4 v[56:59], v1, s[24:27], s31 offen sc1
    buffer_store_dwordx4 v[60:63], v2, s[24:27], s31 offen offset:1024 sc1
    buffer_store_dwordx4 v[64:67], v3, s[24:27], s31 offen offset:2048 sc1
    buffer_store_dwordx4 v[68:71], v4, s[24:27], s31 offen sc1
    buffer_store_dwordx4 v[72:75], v5, s[24:27], s31 offen offset:1024 sc1
    buffer_store_dwordx4 v[76:79], v6, s[24:27], s31 offen offset:2048 sc1
    s_add_i32 s31, s31, s29
    buffer_store_dwordx4 v[80:83], v1, s[24:27], s31 offen sc1
    buffer_store_dwordx4 v[84:87], v2, s[24:27], s31 offen offset:1024 sc1
    buffer_store_dwordx4 v[88:91], v3, s[24:27], s31 offen offset:2048 sc1
    buffer_store_dwordx4 v[92:95], v4, s[24:27], s31 offen sc1
    buffer_store_dwordx4 v[96:99], v5, s[24:27], s31 offen offset:1024 sc1
    buffer_store_dwordx4 v[100:103], v6, s[24:27], s31 offen offset:2048 sc1
    s_add_i32 s31, s31, s29
    buffer_store_dwordx4 v[104:107], v1, s[24:27], s31 offen sc1
    buffer_store_dwordx4 v[108:111], v2, s[24:27], s31 offen offset:1024 sc1
    buffer_store_dwordx4 v[112:115], v3, s[24:27], s31 offen offset:2048 sc1
    buffer_store_dwordx4 v[116:119], v4, s[24:27], s31 offen sc1
    buffer_store_dwordx4 v[120:123], v5, s[24:27], s31 offen offset:1024 sc1
    buffer_store_dwordx4 v[124:127], v6, s[24:27], s31 offen offset:2048 sc1
    s_add_i32 s31, s31, s29
    s_cmp_eq_u32 s28, 5
    s_cbranch_scc0 L_st_end
    buffer_store_dwordx4 v[128:131], v1, s[24:27], s31 offen sc1
    buffer_store_dwordx4 v[132:135], v2, s[24:27], s31 offen offset:1024 sc1
    buffer_store_dwordx4 v[136:139], v3, s[24:27], s31 offen offset:2048 sc1
    buffer_store_dwordx4 v[140:143], v4, s[24:27], s31 offen sc1
    buffer_store_dwordx4 v[144:147], v5, s[24:27], s31 offen offset:1024 sc1
    buffer_store_dwordx4 v[148:151], v6, s[24:27], s31 offen offset:2048 sc1
    s_add_i32 s31, s31, s29
    buffer_store_dwordx4 v[152:155], v1, s[24:27], s31 offen sc1
    buffer_store_dwordx4 v[156:159], v2, s[24:27], s31 offen offset:1024 sc1
    buffer_store_dwordx4 v[160:163], v3, s[24:27], s31 offen offset:2048 sc1
    buffer_store_dwordx4 v[164:167], v4, s[24:27], s31 offen sc1
    buffer_store_dwordx4 v[168:171], v5, s[24:27], s31 offen offset:1024 sc1
    buffer_store_dwordx4 v[172:175], v6, s[24:27], s31 offen offset:2048 sc1
    s_add_i32 s31, s31, s29
    buffer_store_dwordx4 v[176:179], v1, s[24:27], s31 offen sc1
    buffer_store_dwordx4 v[180:183], v2, s[24:27], s31 offen offset:1024 sc1
    buffer_store_dwordx4 v[184:187], v3, s[24:27], s31 offen offset:2048 sc1
    buffer_store_dwordx4 v[188:191], v4, s[24:27], s31 offen sc1
    buffer_store_dwordx4 v[192:195], v5, s[24:27], s31 offen offset:1024 sc1
    buffer_store_dwordx4 v[196:199], v6, s[24:27], s31 offen offset:2048 sc1
    s_add_i32 s31, s31, s29
    buffer_store_dwordx4 v[200:203], v1, s[24:27], s31 offen sc1
    buffer_store_dwordx4 v[204:207], v2, s[24:27], s31 offen offset:1024 sc1
    buffer_store_dwordx4 v[208:211], v3, s[24:27], s31 offen offset:2048 sc1
    buffer_store_dwordx4 v[212:215], v4, s[24:27], s31 offen sc1
    buffer_store_dwordx4 v[216:219], v5, s[24:27], s31 offen offset:1024 sc1
    buffer_store_dwordx4 v[220:223], v6, s[24:27], s31 offen offset:2048 sc1
    s_add_i32 s31, s31, s29
L_st_end:
    s_branch L_fin
L_compute:
    s_sub_u32 s34, s28, 1
    s_mul_i32 s49, s34, 6144
    s_add_u32 s50, s49, 135168
    s_mov_b32 s35, 0
    v_mov_b32 v25, 159744
    s_cmp_ge_u32 s28, 5
    s_cbranch_scc1 L_storer
    v_and_b32 v66, 15, v7
    v_lshrrev_b32 v67, 4, v7
    v_lshrrev_b32 v71, 1, v66
    v_xor_b32 v71, v71, v66
    v_and_b32 v71, 4, v71
    v_and_or_b32 v71, v66, 2, v71
    v_bfe_u32 v70, v66, 3, 1
    v_or_b32 v70, v70, v71
    v_lshlrev_b32 v70, 4, v70
    v_mul_u32_u24 v68, 384, v66
    v_lshlrev_b32 v69, 4, v67
    v_xor_b32 v69, v69, v70
    v_add3_u32 v8, v68, v69, s49
    v_xor_b32 v9, 64, v8
    v_add_u32 v10, 110592, v8
    v_add_u32 v11, 110592, v9
    v_lshrrev_b32 v69, 1, v67
    v_lshlrev_b32 v69, 4, v69
    v_xor_b32 v69, v69, v70
    v_and_b32 v71, 1, v67
    v_lshl_add_u32 v69, v71, 3, v69
    v_add3_u32 v16, v68, v69, s50
    v_subrev_u32 v16, 24576, v16
    v_xor_b32 v17, 32, v16
    v_xor_b32 v18, 64, v16
    v_xor_b32 v19, 96, v16
    v_lshlrev_b32 v69, 2, v67
    v_add_u32 v71, 0, v69
    v_cmp_le_u32 s[36:37], v71, v66
    v_add_u32 v71, 1, v69
    v_cmp_le_u32 s[38:39], v71, v66
    v_add_u32 v71, 2, v69
    v_cmp_le_u32 s[40:41], v71, v66
    v_add_u32 v71, 3, v69
    v_cmp_le_u32 s[42:43], v71, v66
    s_ashr_i32 s46, s29, 31
    s_mov_b32 s47, s46
    s_nop 1
    s_xor_b64 s[36:37], s[36:37], s[46:47]
    s_xor_b64 s[38:39], s[38:39], s[46:47]
    s_xor_b64 s[40:41], s[40:41], s[46:47]
    s_xor_b64 s[42:43], s[42:43], s[46:47]
    s_mov_b32 s52, 0xffff0000
    v_mov_b32 v72, 0xffff
    v_mov_b32 v73, s52
    v_cndmask_b32 v74, 0, v72, s[36:37]
    v_cndmask_b32 v75, 0, v73, s[38:39]
    v_or_b32 v21, v74, v75
    v_not_b32 v23, v21
    v_cndmask_b32 v74, 0, v72, s[40:41]
    v_cndmask_b32 v75, 0, v73, s[42:43]
    v_or_b32 v22, v74, v75
    v_not_b32 v24, v22
    v_lshrrev_b32 v69, 2, v7
    v_lshrrev_b32 v71, 1, v69
    v_xor_b32 v71, v71, v69
    v_and_b32 v71, 4, v71
    v_and_or_b32 v71, v69, 2, v71
    v_bfe_u32 v70, v69, 3, 1
    v_or_b32 v70, v70, v71
    v_lshlrev_b32 v70, 4, v70
    v_mul_u32_u24 v68, 384, v69
    v_bfe_u32 v71, v7, 1, 1
    v_lshlrev_b32 v71, 4, v71
    v_xor_b32 v70, v70, v71
    v_and_b32 v71, 1, v7
    v_lshl_add_u32 v70, v71, 3, v70
    v_add3_u32 v12, v68, v70, s49
    v_xor_b32 v13, 32, v12
    v_xor_b32 v14, 64, v12
    v_xor_b32 v15, 96, v12
    v_lshlrev_b32 v20, 4, v7
    v_add_u32 v20, s50, v20
    s_mov_b32 s34, 12
    s_mov_b32 s35, -1
    s_mov_b64 vcc, 0
    s_mov_b64 exec, 0
    s_branch L_qk
L_real:
    s_mov_b64 exec, -1
    s_mov_b32 s35, 0
    s_sub_u32 s34, s28, 1
    s_cmp_eq_u32 s33, 0
    s_cselect_b32 s48, 0xff800000, 0
    s_cmp_lt_u32 s34, 2
    s_cselect_b32 s56, s48, 0
    s_cmp_eq_u32 s34, 0
    s_cselect_b32 s57, s48, 0
    s_mov_b32 s44, 0x3d93cd3a
    s_mov_b32 s45, 0x3fb8aa3b
    s_movk_i32 s49, 24576
L_qk:
    v_mov_b32 v128, s56
    v_mov_b32 v132, s57
    v_mov_b32 v129, s56
    v_mov_b32 v133, s57
    v_mov_b32 v130, s56
    v_mov_b32 v134, s57
    v_mov_b32 v131, s56
    v_mov_b32 v135, s57
    s_mov_b32 s56, 0
    s_mov_b32 s57, 0
    v_mov_b32 v30, v36
    v_mov_b32 v31, v37
    v_mov_b32 v32, v38
    v_mov_b32 v33, v39
    v_mov_b32 v34, v40
    v_mov_b32 v35, v41
    v_mov_b32 v36, v42
    v_mov_b32 v37, v43
    v_mov_b32 v38, v44
    v_mov_b32 v39, v45
    v_mov_b32 v40, v46
    v_mov_b32 v41, v47
    v_mov_b32 v42, v48
    v_mov_b32 v43, v49
    v_mov_b32 v44, v50
    v_mov_b32 v45, v51
    v_mov_b32 v46, v52
    v_mov_b32 v47, v53
    s_add_u32 s47, s34, 1
    v_mov_b32 v28, s47
    s_add_u32 s53, s34, 19
    s_mul_i32 s53, s53, 6
    s_cmp_ge_u32 s35, s53
    s_cbranch_scc1 L_go1
L_poll1:
    ds_read_b32 v27, v25
    s_waitcnt lgkmcnt(0)
    v_readfirstlane_b32 s35, v27
    s_nop 0
    s_cmp_ge_u32 s35, s53
    s_cbranch_scc1 L_go1
    s_sleep 1
    s_branch L_poll1
L_go1:
    ds_read_b128 v[56:59], v10 offset:0
    ds_read_b128 v[80:83], v8 offset:0
    ds_read_b128 v[84:87], v8 offset:6144
    ds_read_b128 v[88:91], v8 offset:12288
    ds_read_b128 v[60:63], v11 offset:0
    ds_read_b128 v[92:95], v9 offset:0
    ds_read_b128 v[96:99], v9 offset:6144
    ds_read_b128 v[100:103], v9 offset:12288
    ds_read_b128 v[64:67], v10 offset:128
    ds_read_b128 v[104:107], v8 offset:128
    ds_read_b128 v[108:111], v8 offset:6272
    ds_read_b128 v[112:115], v8 offset:12416
    s_waitcnt lgkmcnt(8)
    v_mfma_f32_16x16x32_bf16 v[128:131], v[80:83], v[56:59], v[128:131]
    v_mfma_f32_16x16x32_bf16 v[132:135], v[84:87], v[56:59], v[132:135]
    v_mfma_f32_16x16x32_bf16 v[136:139], v[88:91], v[56:59], 0
    ds_read_b128 v[68:71], v11 offset:128
    ds_read_b128 v[116:119], v9 offset:128
    ds_read_b128 v[120:123], v9 offset:6272
    ds_read_b128 v[124:127], v9 offset:12416
    s_waitcnt lgkmcnt(8)
    v_mfma_f32_16x16x32_bf16 v[128:131], v[92:95], v[60:63], v[128:131]
    v_mfma_f32_16x16x32_bf16 v[132:135], v[96:99], v[60:63], v[132:135]
    v_mfma_f32_16x16x32_bf16 v[136:139], v[100:103], v[60:63], v[136:139]
    ds_read_b128 v[72:75], v10 offset:256
    ds_read_b128 v[80:83], v8 offset:256
    ds_read_b128 v[84:87], v8 offset:6400
    ds_read_b128 v[88:91], v8 offset:12544
    s_waitcnt lgkmcnt(8)
    v_mfma_f32_16x16x32_bf16 v[128:131], v[104:107], v[64:67], v[128:131]
    v_mfma_f32_16x16x32_bf16 v[132:135], v[108:111], v[64:67], v[132:135]
    v_mfma_f32_16x16x32_bf16 v[136:139], v[112:115], v[64:67], v[136:139]
    ds_read_b128 v[76:79], v11 offset:256
    ds_read_b128 v[92:95], v9 offset:256
    ds_read_b128 v[96:99], v9 offset:6400
    ds_read_b128 v[100:103], v9 offset:12544
    s_waitcnt lgkmcnt(8)
    v_mfma_f32_16x16x32_bf16 v[128:131], v[116:119], v[68:71], v[128:131]
    v_mfma_f32_16x16x32_bf16 v[132:135], v[120:123], v[68:71], v[132:135]
    v_mfma_f32_16x16x32_bf16 v[136:139], v[124:127], v[68:71], v[136:139]
    s_waitcnt lgkmcnt(4)
    v_mfma_f32_16x16x32_bf16 v[128:131], v[80:83], v[72:75], v[128:131]
    v_mfma_f32_16x16x32_bf16 v[132:135], v[84:87], v[72:75], v[132:135]
    v_mfma_f32_16x16x32_bf16 v[136:139], v[88:91], v[72:75], v[136:139]
    s_waitcnt lgkmcnt(0)
    ds_write_b32 v26, v28
    v_mfma_f32_16x16x32_bf16 v[128:131], v[92:95], v[76:79], v[128:131]
    v_mfma_f32_16x16x32_bf16 v[132:135], v[96:99], v[76:79], v[132:135]
    v_mfma_f32_16x16x32_bf16 v[136:139], v[100:103], v[76:79], v[136:139]
    v_add_u32 v8, 24576, v8
    v_add_u32 v9, 24576, v9
    v_add_u32 v10, s49, v10
    v_add_u32 v11, s49, v11
    s_sub_i32 s49, 0, s49
    s_add_u32 s34, s34, 4
    s_nop 2
    v_cndmask_b32 v140, v128, v136, s[36:37]
    v_cndmask_b32 v141, v129, v137, s[38:39]
    v_cndmask_b32 v142, v130, v138, s[40:41]
    v_cndmask_b32 v143, v131, v139, s[42:43]
    v_cvt_pk_bf16_f32 v148, v140, v141
    v_cvt_pk_bf16_f32 v149, v142, v143
    v_cvt_pk_bf16_f32 v150, v132, v133
    v_cvt_pk_bf16_f32 v151, v134, v135
    v_lshlrev_b32 v140, 16, v148
    v_and_b32 v141, s52, v148
    v_lshlrev_b32 v142, 16, v149
    v_and_b32 v143, s52, v149
    v_lshlrev_b32 v144, 16, v150
    v_and_b32 v145, s52, v150
    v_lshlrev_b32 v146, 16, v151
    v_and_b32 v147, s52, v151
    v_mul_f32 v140, s44, v140
    v_mul_f32 v141, s44, v141
    v_mul_f32 v142, s44, v142
    v_mul_f32 v143, s44, v143
    v_mul_f32 v144, s44, v144
    v_mul_f32 v145, s44, v145
    v_mul_f32 v146, s44, v146
    v_mul_f32 v147, s44, v147
    v_cvt_pk_bf16_f32 v148, v140, v141
    v_cvt_pk_bf16_f32 v149, v142, v143
    v_cvt_pk_bf16_f32 v150, v144, v145
    v_cvt_pk_bf16_f32 v151, v146, v147
    v_lshlrev_b32 v140, 16, v148
    v_and_b32 v141, s52, v148
    v_lshlrev_b32 v142, 16, v149
    v_and_b32 v143, s52, v149
    v_lshlrev_b32 v144, 16, v150
    v_and_b32 v145, s52, v150
    v_lshlrev_b32 v146, 16, v151
    v_and_b32 v147, s52, v151
    v_max3_f32 v152, v140, v141, v142
    v_max3_f32 v153, v143, v144, v145
    v_max3_f32 v152, v152, v146, v147
    v_max_f32 v152, v152, v153
    v_mov_b32 v153, v152
    s_nop 1
    v_permlane16_swap_b32 v152, v153
    s_nop 0
    v_max_f32 v152, v152, v153
    v_mov_b32 v153, v152
    s_nop 1
    v_permlane32_swap_b32 v152, v153
    s_nop 0
    v_max_f32 v152, v152, v153
    v_mul_f32 v152, s45, v152
    v_fma_f32 v140, v140, s45, -v152
    v_fma_f32 v141, v141, s45, -v152
    v_fma_f32 v142, v142, s45, -v152
    v_fma_f32 v143, v143, s45, -v152
    v_fma_f32 v144, v144, s45, -v152
    v_fma_f32 v145, v145, s45, -v152
    v_fma_f32 v146, v146, s45, -v152
    v_fma_f32 v147, v147, s45, -v152
    v_exp_f32 v140, v140
    v_exp_f32 v141, v141
    v_exp_f32 v142, v142
    v_exp_f32 v143, v143
    v_exp_f32 v144, v144
    v_exp_f32 v145, v145
    v_exp_f32 v146, v146
    v_exp_f32 v147, v147
    v_add_f32 v154, v140, v141
    v_add_f32 v155, v142, v143
    v_add_f32 v154, v154, v144
    v_add_f32 v155, v155, v145
    v_add_f32 v154, v154, v146
    v_add_f32 v155, v155, v147
    v_add_f32 v154, v154, v155
    v_mov_b32 v155, v154
    s_nop 1
    v_permlane16_swap_b32 v154, v155
    s_nop 0
    v_add_f32 v154, v154, v155
    v_mov_b32 v155, v154
    s_nop 1
    v_permlane32_swap_b32 v154, v155
    s_nop 0
    v_add_f32 v154, v154, v155
    v_rcp_f32 v154, v154
    s_nop 0
    v_mul_f32 v140, v140, v154
    v_mul_f32 v141, v141, v154
    v_mul_f32 v142, v142, v154
    v_mul_f32 v143, v143, v154
    v_mul_f32 v144, v144, v154
    v_mul_f32 v145, v145, v154
    v_mul_f32 v146, v146, v154
    v_mul_f32 v147, v147, v154
    v_cvt_pk_bf16_f32 v148, v140, v141
    v_cvt_pk_bf16_f32 v149, v142, v143
    v_cvt_pk_bf16_f32 v50, v144, v145
    v_cvt_pk_bf16_f32 v51, v146, v147
    v_and_b32 v48, v148, v23
    v_and_b32 v49, v149, v24
    v_and_b32 v52, v148, v21
    v_and_b32 v53, v149, v22
    s_cmp_lt_u32 s34, 16
    s_cbranch_scc1 L_qk
    s_sub_u32 s66, s34, 4
    s_sub_u32 s34, s34, 16
    s_mul_i32 s66, s66, s29
    s_add_i32 s66, s66, s31
    s_movk_i32 s67, 24576
    v_mov_b32 v28, 32
L_pv:
    s_add_u32 s53, s34, 36
    s_mul_i32 s53, s53, 6
    s_cmp_ge_u32 s35, s53
    s_cbranch_scc1 L_go2
L_poll2:
    ds_read_b32 v27, v25
    s_waitcnt lgkmcnt(0)
    v_readfirstlane_b32 s35, v27
    s_nop 0
    s_cmp_ge_u32 s35, s53
    s_cbranch_scc1 L_go2
    s_sleep 1
    s_branch L_poll2
L_go2:
    ds_read_b64_tr_b16 v[80:81], v12 offset:0
    ds_read_b64_tr_b16 v[82:83], v12 offset:6144
    ds_read_b64_tr_b16 v[84:85], v13 offset:0
    ds_read_b64_tr_b16 v[86:87], v13 offset:6144
    ds_read_b64_tr_b16 v[88:89], v14 offset:0
    ds_read_b64_tr_b16 v[90:91], v14 offset:6144
    ds_read_b64_tr_b16 v[92:93], v15 offset:0
    ds_read_b64_tr_b16 v[94:95], v15 offset:6144
    ds_read_b64_tr_b16 v[96:97], v12 offset:128
    ds_read_b64_tr_b16 v[98:99], v12 offset:6272
    ds_read_b64_tr_b16 v[100:101], v13 offset:128
    ds_read_b64_tr_b16 v[102:103], v13 offset:6272
    s_waitcnt lgkmcnt(10)
    v_mfma_f32_16x16x32_bf16 v[112:115], v[80:83], v[30:33], 0
    ds_read_b64_tr_b16 v[104:105], v14 offset:128
    ds_read_b64_tr_b16 v[106:107], v14 offset:6272
    s_waitcnt lgkmcnt(10)
    v_mfma_f32_16x16x32_bf16 v[116:119], v[84:87], v[30:33], 0
    ds_read_b64_tr_b16 v[108:109], v15 offset:128
    ds_read_b64_tr_b16 v[110:111], v15 offset:6272
    s_waitcnt lgkmcnt(10)
    v_mfma_f32_16x16x32_bf16 v[120:123], v[88:91], v[30:33], 0
    ds_read_b64_tr_b16 v[80:81], v12 offset:256
    ds_read_b64_tr_b16 v[82:83], v12 offset:6400
    s_waitcnt lgkmcnt(10)
    v_mfma_f32_16x16x32_bf16 v[124:127], v[92:95], v[30:33], 0
    ds_read_b64_tr_b16 v[84:85], v13 offset:256
    ds_read_b64_tr_b16 v[86:87], v13 offset:6400
    s_waitcnt lgkmcnt(10)
    v_mfma_f32_16x16x32_bf16 v[128:131], v[96:99], v[30:33], 0
    ds_read_b64_tr_b16 v[88:89], v14 offset:256
    ds_read_b64_tr_b16 v[90:91], v14 offset:6400
    s_waitcnt lgkmcnt(10)
    v_mfma_f32_16x16x32_bf16 v[132:135], v[100:103], v[30:33], 0
    ds_read_b64_tr_b16 v[92:93], v15 offset:256
    ds_read_b64_tr_b16 v[94:95], v15 offset:6400
    s_waitcnt lgkmcnt(10)
    v_mfma_f32_16x16x32_bf16 v[136:139], v[104:107], v[30:33], 0
    s_waitcnt lgkmcnt(8)
    v_mfma_f32_16x16x32_bf16 v[140:143], v[108:111], v[30:33], 0
    s_waitcnt lgkmcnt(6)
    v_mfma_f32_16x16x32_bf16 v[144:147], v[80:83], v[30:33], 0
    s_waitcnt lgkmcnt(4)
    v_mfma_f32_16x16x32_bf16 v[148:151], v[84:87], v[30:33], 0
    s_waitcnt lgkmcnt(2)
    v_mfma_f32_16x16x32_bf16 v[152:155], v[88:91], v[30:33], 0
    s_waitcnt lgkmcnt(0)
    v_mfma_f32_16x16x32_bf16 v[156:159], v[92:95], v[30:33], 0
    s_add_u32 s53, s53, 6
    s_lshr_b32 s46, s34, 2
    s_sub_i32 s46, s46, 1
L_copied:
    ds_read_b32 v27, v25 offset:1536
    s_waitcnt lgkmcnt(0)
    v_cmp_gt_i32 vcc, s46, v27
    s_cbranch_vccnz L_copied
    s_cmp_ge_u32 s35, s53
    s_cbranch_scc1 L_go3
L_poll3:
    ds_read_b32 v27, v25
    s_waitcnt lgkmcnt(0)
    v_readfirstlane_b32 s35, v27
    s_nop 0
    s_cmp_ge_u32 s35, s53
    s_cbranch_scc1 L_go3
    s_sleep 1
    s_branch L_poll3
L_go3:
    ds_read_b64_tr_b16 v[56:57], v12 offset:12288
    ds_read_b64_tr_b16 v[58:59], v13 offset:12288
    ds_read_b64_tr_b16 v[60:61], v14 offset:12288
    ds_read_b64_tr_b16 v[62:63], v15 offset:12288
    ds_read_b64_tr_b16 v[64:65], v12 offset:12416
    ds_read_b64_tr_b16 v[66:67], v13 offset:12416
    ds_read_b64_tr_b16 v[68:69], v14 offset:12416
    ds_read_b64_tr_b16 v[70:71], v15 offset:12416
    ds_read_b64_tr_b16 v[72:73], v12 offset:12544
    ds_read_b64_tr_b16 v[74:75], v13 offset:12544
    ds_read_b64_tr_b16 v[76:77], v14 offset:12544
    ds_read_b64_tr_b16 v[78:79], v15 offset:12544
    s_waitcnt lgkmcnt(11)
    v_mfma_f32_16x16x16_bf16 v[112:115], v[56:57], v[34:35], v[112:115]
    s_waitcnt lgkmcnt(10)
    v_mfma_f32_16x16x16_bf16 v[116:119], v[58:59], v[34:35], v[116:119]
    s_waitcnt lgkmcnt(9)
    v_mfma_f32_16x16x16_bf16 v[120:123], v[60:61], v[34:35], v[120:123]
    s_waitcnt lgkmcnt(8)
    v_mfma_f32_16x16x16_bf16 v[124:127], v[62:63], v[34:35], v[124:127]
    s_waitcnt lgkmcnt(7)
    v_mfma_f32_16x16x16_bf16 v[128:131], v[64:65], v[34:35], v[128:131]
    v_cvt_pk_bf16_f32 v80, v112, v113
    v_cvt_pk_bf16_f32 v81, v114, v115
    ds_write_b64 v16, v[80:81] offset:0
    s_waitcnt lgkmcnt(7)
    v_mfma_f32_16x16x16_bf16 v[132:135], v[66:67], v[34:35], v[132:135]
    v_cvt_pk_bf16_f32 v82, v116, v117
    v_cvt_pk_bf16_f32 v83, v118, v119
    ds_write_b64 v17, v[82:83] offset:0
    s_waitcnt lgkmcnt(7)
    v_mfma_f32_16x16x16_bf16 v[136:139], v[68:69], v[34:35], v[136:139]
    v_cvt_pk_bf16_f32 v84, v120, v121
    v_cvt_pk_bf16_f32 v85, v122, v123
    ds_write_b64 v18, v[84:85] offset:0
    s_waitcnt lgkmcnt(7)
    v_mfma_f32_16x16x16_bf16 v[140:143], v[70:71], v[34:35], v[140:143]
    v_cvt_pk_bf16_f32 v86, v124, v125
    v_cvt_pk_bf16_f32 v87, v126, v127
    ds_write_b64 v19, v[86:87] offset:0
    s_waitcnt lgkmcnt(7)
    v_mfma_f32_16x16x16_bf16 v[144:147], v[72:73], v[34:35], v[144:147]
    v_cvt_pk_bf16_f32 v88, v128, v129
    v_cvt_pk_bf16_f32 v89, v130, v131
    ds_write_b64 v16, v[88:89] offset:128
    s_waitcnt lgkmcnt(7)
    v_mfma_f32_16x16x16_bf16 v[148:151], v[74:75], v[34:35], v[148:151]
    v_cvt_pk_bf16_f32 v90, v132, v133
    v_cvt_pk_bf16_f32 v91, v134, v135
    ds_write_b64 v17, v[90:91] offset:128
    s_waitcnt lgkmcnt(7)
    v_mfma_f32_16x16x16_bf16 v[152:155], v[76:77], v[34:35], v[152:155]
    v_cvt_pk_bf16_f32 v92, v136, v137
    v_cvt_pk_bf16_f32 v93, v138, v139
    ds_write_b64 v18, v[92:93] offset:128
    s_waitcnt lgkmcnt(7)
    v_mfma_f32_16x16x16_bf16 v[156:159], v[78:79], v[34:35], v[156:159]
    v_cvt_pk_bf16_f32 v94, v140, v141
    v_cvt_pk_bf16_f32 v95, v142, v143
    ds_write_b64 v19, v[94:95] offset:128
    v_cvt_pk_bf16_f32 v96, v144, v145
    v_cvt_pk_bf16_f32 v97, v146, v147
    ds_write_b64 v16, v[96:97] offset:256
    v_cvt_pk_bf16_f32 v98, v148, v149
    v_cvt_pk_bf16_f32 v99, v150, v151
    ds_write_b64 v17, v[98:99] offset:256
    v_cvt_pk_bf16_f32 v100, v152, v153
    v_cvt_pk_bf16_f32 v101, v154, v155
    ds_write_b64 v18, v[100:101] offset:256
    v_cvt_pk_bf16_f32 v102, v156, v157
    v_cvt_pk_bf16_f32 v103, v158, v159
    ds_write_b64 v19, v[102:103] offset:256
    s_cmp_ge_u32 s34, 12
    s_cbranch_scc1 L_last
    s_add_u32 s34, s34, 4
    v_mov_b32 v30, v36
    v_mov_b32 v31, v37
    v_mov_b32 v32, v38
    v_mov_b32 v33, v39
    v_mov_b32 v34, v40
    v_mov_b32 v35, v41
    v_mov_b32 v36, v42
    v_mov_b32 v37, v43
    v_mov_b32 v38, v44
    v_mov_b32 v39, v45
    v_mov_b32 v40, v46
    v_mov_b32 v41, v47
    v_mov_b32 v42, v48
    v_mov_b32 v43, v49
    v_mov_b32 v44, v50
    v_mov_b32 v45, v51
    v_mov_b32 v46, v52
    v_mov_b32 v47, v53
    v_add_u32 v12, 24576, v12
    v_add_u32 v13, 24576, v13
    v_add_u32 v14, 24576, v14
    v_add_u32 v15, 24576, v15
    v_add_u32 v16, s67, v16
    v_add_u32 v17, s67, v17
    v_add_u32 v18, s67, v18
    v_add_u32 v19, s67, v19
    s_sub_i32 s67, 0, s67
    s_waitcnt lgkmcnt(0)
    ds_write_b32 v26, v28
    s_cbranch_execz L_real
    v_add_u32 v28, 1, v28
    s_branch L_pv
L_last:
    s_waitcnt lgkmcnt(0)
    ds_read_b128 v[112:115], v20 offset:0
    ds_read_b128 v[116:119], v20 offset:1024
    ds_read_b128 v[120:123], v20 offset:2048
    ds_read_b128 v[124:127], v20 offset:3072
    ds_read_b128 v[128:131], v20 offset:4096
    ds_read_b128 v[132:135], v20 offset:5120
    s_waitcnt lgkmcnt(5)
    buffer_store_dwordx4 v[112:115], v1, s[24:27], s66 offen sc1
    s_waitcnt lgkmcnt(4)
    buffer_store_dwordx4 v[116:119], v2, s[24:27], s66 offen offset:1024 sc1
    s_waitcnt lgkmcnt(3)
    buffer_store_dwordx4 v[120:123], v3, s[24:27], s66 offen offset:2048 sc1
    s_waitcnt lgkmcnt(2)
    buffer_store_dwordx4 v[124:127], v4, s[24:27], s66 offen sc1
    s_waitcnt lgkmcnt(1)
    buffer_store_dwordx4 v[128:131], v5, s[24:27], s66 offen offset:1024 sc1
    s_waitcnt lgkmcnt(0)
    buffer_store_dwordx4 v[132:135], v6, s[24:27], s66 offen offset:2048 sc1
L_fin:
L_end:
    s_endpgm
.section .rodata,"a"
.p2align 6
.amdhsa_kernel standalone__sliding_local_fixed_window__prompt_kernel
  .amdhsa_next_free_vgpr 232
  .amdhsa_next_free_sgpr 80
  .amdhsa_accum_offset 232
  .amdhsa_group_segment_fixed_size 0
  .amdhsa_kernarg_size 48
  .amdhsa_user_sgpr_count 2
  .amdhsa_user_sgpr_kernarg_segment_ptr 1
  .amdhsa_system_sgpr_workgroup_id_x 1
.end_amdhsa_kernel
```
